```python
import torch

def _softmax(x, axis=-1):
    return torch.softmax(x, dim=axis)
def _gelu(x):
    return torch.nn.functional.gelu(x, approximate="tanh")
def _silu(x):
    return torch.nn.functional.silu(x)
def _sigmoid(x):
    return torch.sigmoid(x)
def _layernorm(x, axis=-1, eps=1e-5):
    m = x.mean(dim=axis, keepdim=True)
    v = x.var(dim=axis, keepdim=True, unbiased=False)
    return (x - m) / torch.sqrt(v + eps)
def _scatter_add(tgt, idx, src, axis=0):
    return tgt.clone().index_add_(axis, idx, src)
def _segment_sum(src, seg, n):
    out = torch.zeros((n,) + src.shape[1:], dtype=src.dtype)
    return out.index_add_(0, seg, src)
def _pad(x, pw):
    flat = tuple(v for pair in reversed(pw) for v in pair)
    return torch.nn.functional.pad(x, flat)

kernel_name = 'standalone__depthwise_separable__vision'

def setup_inputs():

    _w = (lambda a: (lambda t: t.to(torch.bfloat16) if t.is_floating_point() else t)(torch.as_tensor(a)))
    H = W = 384
    C = 192
    k = 1
    return {
        "x": _w((lambda *s: torch.randn(*s, dtype=torch.bfloat16) * 0.05)(1, H, W, C)),
        "dw": _w((lambda *s: torch.randn(*s, dtype=torch.bfloat16) * 0.05)(k, k, C)),
        "pw": _w((lambda *s: torch.randn(*s, dtype=torch.bfloat16) * 0.05)(C, C)),
    }

def reference(x, dw, pw):
    B, H, W, C = x.shape
    k = dw.shape[0]
    pad = k // 2
    xp = _pad(x, ((0,0),(pad,pad),(pad,pad),(0,0)))
    out = torch.zeros_like(x)
    for i in range(k):
        for j in range(k):
            out = out + xp[:, i:i+H, j:j+W, :] * dw[i, j][None, None, None, :]
    return torch.einsum('bhwc,cd->bhwd', out, pw)
```

```asm
; @launch grid=(256,1,1) block=(256,1,1) lds=151680
.amdgcn_target "amdgcn-amd-amdhsa--gfx950"
.text
.globl standalone__depthwise_separable__vision_kernel
.p2align 8
.type standalone__depthwise_separable__vision_kernel,@function
standalone__depthwise_separable__vision_kernel:
    s_cmp_ge_u32 s2, 256
    s_cbranch_scc1 L_end
    s_load_dwordx8 s[4:11], s[0:1], 0
    s_load_dwordx2 s[62:63], s[0:1], 32
    v_lshrrev_b32 v1, 6, v0
    v_and_b32 v0, 63, v0
    v_readfirstlane_b32 s28, v1
    s_getpc_b64 s[38:39]
    v_lshlrev_b32 v39, 7, v0
    global_load_dword v38, v39, s[38:39]
    v_lshrrev_b32 v22, 3, v0
    v_and_b32 v23, 7, v0
    v_mul_u32_u24 v24, 86, v22
    v_lshrrev_b32 v144, 8, v24
    v_xor_b32 v25, v144, v23
    v_lshlrev_b32 v25, 4, v25
    v_lshl_add_u32 v2, v22, 7, v25
    v_xor_b32 v5, 0x50, v2
    v_add_u32 v5, 3072, v5
    v_add_u32 v24, 688, v24
    v_lshrrev_b32 v145, 8, v24
    v_xor_b32 v25, v145, v23
    v_lshlrev_b32 v25, 4, v25
    v_lshl_add_u32 v3, v22, 7, v25
    v_xor_b32 v6, 0x50, v3
    v_add_u32 v6, 3072, v6
    v_add_u32 v24, 688, v24
    v_lshrrev_b32 v146, 8, v24
    v_xor_b32 v25, v146, v23
    v_lshlrev_b32 v25, 4, v25
    v_lshl_add_u32 v4, v22, 7, v25
    v_xor_b32 v7, 0x50, v4
    v_add_u32 v7, 3072, v7
    s_lshr_b32 s45, s2, 3
    s_lshl_b32 s45, s45, 2
    s_and_b32 s35, s2, 3
    s_add_u32 s45, s45, s35
    s_mul_i32 s40, s45, 442368
    s_and_b32 s35, s2, 4
    s_add_u32 s35, s35, s28
    s_mul_i32 s35, s35, 6144
    s_add_u32 s48, s40, s35
    s_mul_i32 s32, s28, 30720
    s_add_u32 s32, s32, 24576
    s_waitcnt lgkmcnt(0)
    s_mov_b32 s12, s4
    s_and_b32 s13, s5, 0xffff
    s_mov_b32 s14, 56623104
    s_mov_b32 s15, 0x20000
    s_mov_b32 m0, s32
    s_nop 0
    buffer_load_dwordx4 v2, s[12:15], s48 offen offset:0 nt lds
    buffer_load_dwordx4 v3, s[12:15], s48 offen offset:1024 nt lds
    buffer_load_dwordx4 v4, s[12:15], s48 offen offset:2048 nt lds
    s_add_u32 m0, s32, 3072
    s_nop 0
    buffer_load_dwordx4 v5, s[12:15], s48 offen offset:0 nt lds
    buffer_load_dwordx4 v6, s[12:15], s48 offen offset:1024 nt lds
    buffer_load_dwordx4 v7, s[12:15], s48 offen offset:2048 nt lds
    s_mov_b32 s16, s6
    s_and_b32 s17, s7, 0xffff
    s_mov_b32 s18, 384
    s_mov_b32 s19, 0x20000
    s_mov_b32 s20, s8
    s_and_b32 s21, s9, 0xffff
    s_mov_b32 s22, 73728
    s_mov_b32 s23, 0x20000
    s_mov_b32 s24, s10
    s_and_b32 s25, s11, 0xffff
    s_mov_b32 s26, 56623104
    s_mov_b32 s27, 0x20000
    s_lshl_b32 s44, s28, 10
    s_add_u32 m0, s44, 147584
    v_lshlrev_b32 v24, 4, v0
    buffer_load_dwordx4 v24, s[16:19], 0 offen lds
    s_add_u32 s49, s48, 49152
    s_add_u32 s50, s49, 49152
    s_cmp_lg_u32 s28, 0
    s_cbranch_scc1 L_wload
    s_add_u32 m0, s32, 6144
    s_nop 0
    buffer_load_dwordx4 v2, s[12:15], s49 offen offset:0 nt lds
    buffer_load_dwordx4 v3, s[12:15], s49 offen offset:1024 nt lds
    buffer_load_dwordx4 v4, s[12:15], s49 offen offset:2048 nt lds
    s_add_u32 m0, s32, 9216
    s_nop 0
    buffer_load_dwordx4 v5, s[12:15], s49 offen offset:0 nt lds
    buffer_load_dwordx4 v6, s[12:15], s49 offen offset:1024 nt lds
    buffer_load_dwordx4 v7, s[12:15], s49 offen offset:2048 nt lds
    s_add_u32 s58, s40, 262143
    s_add_u32 s58, s4, s58
    s_addc_u32 s59, s5, 0
    s_and_b32 s58, s58, 0xffffc000
    s_and_b32 s60, s2, 4
    s_lshl_b32 s60, s60, 7
    s_add_u32 s58, s58, s60
    s_load_dword s60, s[58:59], 0
    s_load_dword s61, s[58:59], 8192
    s_mov_b32 s43, 0
    s_waitcnt lgkmcnt(1)
    s_memtime s[38:39]
    s_waitcnt lgkmcnt(0)
    s_memtime s[60:61]
    s_waitcnt lgkmcnt(0)
    s_sub_u32 s60, s60, s38
    s_cmp_gt_u32 s60, 64
    s_cbranch_scc1 L_found
    s_load_dword s60, s[58:59], 9216
    s_load_dword s61, s[58:59], 1024
    s_mov_b32 s43, 1
    s_waitcnt lgkmcnt(1)
    s_memtime s[38:39]
    s_waitcnt lgkmcnt(0)
    s_memtime s[60:61]
    s_waitcnt lgkmcnt(0)
    s_sub_u32 s60, s60, s38
    s_cmp_gt_u32 s60, 64
    s_cbranch_scc1 L_found
    s_load_dword s60, s[58:59], 2048
    s_load_dword s61, s[58:59], 10240
    s_mov_b32 s43, 0
    s_waitcnt lgkmcnt(1)
    s_memtime s[38:39]
    s_waitcnt lgkmcnt(0)
    s_memtime s[60:61]
    s_waitcnt lgkmcnt(0)
    s_sub_u32 s60, s60, s38
    s_cmp_gt_u32 s60, 64
    s_cbranch_scc1 L_found
    s_mov_b32 s44, 0
    s_branch L_probed
L_found:
    s_bfe_u32 s35, s58, 0x10015
    s_xor_b32 s43, s43, s35
    s_and_b32 s35, s45, 63
    s_lshl_b32 s35, s35, 2
    s_lshr_b32 s36, s45, 6
    s_lshl_b32 s36, s36, 1
    s_add_u32 s36, s36, s43
    s_lshl_b32 s44, 1, s36
    v_mov_b32 v10, s35
    v_mov_b32 v11, s44
    s_mov_b64 exec, 1
    global_atomic_or v21, v10, v11, s[62:63] sc0
    s_mov_b64 exec, -1
L_probed:
    s_branch L_wdone
L_wload:
    v_and_b32 v25, 2, v144
    v_xor_b32 v25, v25, v23
    v_lshlrev_b32 v25, 4, v25
    v_lshl_add_u32 v144, v22, 7, v25
    v_xor_b32 v147, 64, v144
    v_add_u32 v147, 3072, v147
    v_and_b32 v25, 2, v145
    v_xor_b32 v25, v25, v23
    v_lshlrev_b32 v25, 4, v25
    v_lshl_add_u32 v145, v22, 7, v25
    v_xor_b32 v148, 64, v145
    v_add_u32 v148, 3072, v148
    v_and_b32 v25, 2, v146
    v_xor_b32 v25, v25, v23
    v_lshlrev_b32 v25, 4, v25
    v_lshl_add_u32 v146, v22, 7, v25
    v_xor_b32 v149, 64, v146
    v_add_u32 v149, 3072, v149
    s_lshl_b32 s30, s28, 2
    s_sub_u32 s30, s30, 4
    s_mul_i32 s35, s30, 6144
    s_lshr_b32 s36, s30, 1
    s_mul_i32 s36, s36, 30720
    s_sub_u32 s36, s36, 18432
    s_mov_b32 s30, 24576
    s_cmp_eq_u32 s28, 1
    s_cselect_b32 s37, 0, s36
    s_cselect_b32 s30, 6144, s30
    s_mov_b32 m0, s37
    s_nop 0
    buffer_load_dwordx4 v144, s[20:23], s35 offen offset:0 lds
    buffer_load_dwordx4 v145, s[20:23], s35 offen offset:1024 lds
    buffer_load_dwordx4 v146, s[20:23], s35 offen offset:2048 lds
    s_add_u32 m0, s37, 3072
    s_nop 0
    buffer_load_dwordx4 v147, s[20:23], s35 offen offset:0 lds
    buffer_load_dwordx4 v148, s[20:23], s35 offen offset:1024 lds
    buffer_load_dwordx4 v149, s[20:23], s35 offen offset:2048 lds
    s_add_u32 s35, s35, 6144
    s_add_u32 s37, s37, 6144
    s_mov_b32 m0, s37
    s_nop 0
    buffer_load_dwordx4 v144, s[20:23], s35 offen offset:0 lds
    buffer_load_dwordx4 v145, s[20:23], s35 offen offset:1024 lds
    buffer_load_dwordx4 v146, s[20:23], s35 offen offset:2048 lds
    s_add_u32 m0, s37, 3072
    s_nop 0
    buffer_load_dwordx4 v147, s[20:23], s35 offen offset:0 lds
    buffer_load_dwordx4 v148, s[20:23], s35 offen offset:1024 lds
    buffer_load_dwordx4 v149, s[20:23], s35 offen offset:2048 lds
    s_add_u32 s35, s35, 6144
    s_add_u32 s37, s37, s30
    s_mov_b32 m0, s37
    s_nop 0
    buffer_load_dwordx4 v144, s[20:23], s35 offen offset:0 lds
    buffer_load_dwordx4 v145, s[20:23], s35 offen offset:1024 lds
    buffer_load_dwordx4 v146, s[20:23], s35 offen offset:2048 lds
    s_add_u32 m0, s37, 3072
    s_nop 0
    buffer_load_dwordx4 v147, s[20:23], s35 offen offset:0 lds
    buffer_load_dwordx4 v148, s[20:23], s35 offen offset:1024 lds
    buffer_load_dwordx4 v149, s[20:23], s35 offen offset:2048 lds
    s_add_u32 s35, s35, 6144
    s_add_u32 s37, s37, 6144
    s_mov_b32 m0, s37
    s_nop 0
    buffer_load_dwordx4 v144, s[20:23], s35 offen offset:0 lds
    buffer_load_dwordx4 v145, s[20:23], s35 offen offset:1024 lds
    buffer_load_dwordx4 v146, s[20:23], s35 offen offset:2048 lds
    s_add_u32 m0, s37, 3072
    s_nop 0
    buffer_load_dwordx4 v147, s[20:23], s35 offen offset:0 lds
    buffer_load_dwordx4 v148, s[20:23], s35 offen offset:1024 lds
    buffer_load_dwordx4 v149, s[20:23], s35 offen offset:2048 lds
    s_add_u32 m0, s32, 6144
    s_nop 0
    buffer_load_dwordx4 v2, s[12:15], s49 offen offset:0 nt lds
    buffer_load_dwordx4 v3, s[12:15], s49 offen offset:1024 nt lds
    buffer_load_dwordx4 v4, s[12:15], s49 offen offset:2048 nt lds
    s_add_u32 m0, s32, 9216
    s_nop 0
    buffer_load_dwordx4 v5, s[12:15], s49 offen offset:0 nt lds
    buffer_load_dwordx4 v6, s[12:15], s49 offen offset:1024 nt lds
    buffer_load_dwordx4 v7, s[12:15], s49 offen offset:2048 nt lds
L_wdone:
    v_lshrrev_b32 v22, 4, v0
    v_and_b32 v23, 15, v0
    v_lshrrev_b32 v25, 3, v23
    v_mul_u32_u24 v25, 13, v25
    v_xor_b32 v25, v25, v23
    v_mul_u32_u24 v23, 384, v23
    v_xor_b32 v24, v22, v25
    v_lshl_add_u32 v8, v24, 4, v23
    v_add_u32 v8, s32, v8
    v_xor_b32 v9, 64, v8
    v_lshrrev_b32 v24, 1, v22
    v_xor_b32 v24, v24, v25
    v_lshl_add_u32 v12, v24, 4, v23
    v_and_b32 v24, 1, v22
    v_lshl_add_u32 v12, v24, 3, v12
    s_mul_i32 s35, s28, 6144
    v_add_u32 v12, s35, v12
    v_xor_b32 v13, 32, v12
    v_xor_b32 v14, 64, v12
    v_xor_b32 v15, 96, v12
    v_lshlrev_b32 v16, 4, v0
    v_add_u32 v16, s35, v16
    v_bfe_u32 v23, v0, 2, 2
    v_lshl_add_u32 v24, v22, 3, v23
    v_mul_u32_u24 v24, 384, v24
    v_and_b32 v25, 3, v0
    v_lshl_add_u32 v24, v25, 3, v24
    v_lshrrev_b32 v23, 1, v23
    v_and_b32 v25, 1, v22
    v_lshl_add_u32 v23, v25, 1, v23
    v_lshl_add_u32 v17, v23, 5, v24
    v_xor_b32 v18, 32, v17
    v_xor_b32 v19, 64, v17
    v_xor_b32 v20, 96, v17
    s_lshl_b32 s35, s28, 10
    s_add_u32 s35, s35, 147584
    v_lshl_add_u32 v1, v22, 4, s35
    s_mov_b32 s34, 0xffff0000
    s_mov_b32 s31, 6144
    s_mov_b32 s29, 24576
    s_mov_b32 s33, 0
    v_mul_u32_u24 v23, 6144, v0
    s_add_u32 s35, s4, 3072
    v_add_u32 v23, s35, v23
    v_and_b32 v23, 0x2000, v23
    v_cmp_ne_u32 vcc, 0, v23
    s_add_u32 s36, s40, s4
    s_add_u32 s40, s40, 147456
    s_nop 1
    s_and_b32 s42, vcc_lo, 0xff
    s_xor_b32 s41, s42, 0xff
    s_sub_u32 s35, s41, 1
    s_and_b32 s35, s35, s41
    s_cmp_ge_u32 s28, 1
    s_cselect_b32 s41, s35, s41
    s_sub_u32 s35, s41, 1
    s_and_b32 s35, s35, s41
    s_cmp_ge_u32 s28, 2
    s_cselect_b32 s41, s35, s41
    s_sub_u32 s35, s41, 1
    s_and_b32 s35, s35, s41
    s_cmp_ge_u32 s28, 3
    s_cselect_b32 s41, s35, s41
    s_ff1_i32_b32 s41, s41
    s_mul_i32 s41, s41, 6144
    s_sub_u32 s35, s42, 1
    s_and_b32 s35, s35, s42
    s_cmp_ge_u32 s28, 1
    s_cselect_b32 s42, s35, s42
    s_sub_u32 s35, s42, 1
    s_and_b32 s35, s35, s42
    s_cmp_ge_u32 s28, 2
    s_cselect_b32 s42, s35, s42
    s_sub_u32 s35, s42, 1
    s_and_b32 s35, s35, s42
    s_cmp_ge_u32 s28, 3
    s_cselect_b32 s42, s35, s42
    s_ff1_i32_b32 s42, s42
    s_mul_i32 s42, s42, 6144
    s_add_u32 s35, s36, 172032
    s_bitcmp1_b32 s35, 21
    s_cselect_b32 s51, s42, s41
    s_add_u32 s35, s36, 221184
    s_bitcmp1_b32 s35, 21
    s_cselect_b32 s52, s42, s41
    s_add_u32 s35, s36, 270336
    s_bitcmp1_b32 s35, 21
    s_cselect_b32 s53, s42, s41
    s_add_u32 s35, s36, 319488
    s_bitcmp1_b32 s35, 21
    s_cselect_b32 s54, s42, s41
    s_add_u32 s35, s36, 368640
    s_bitcmp1_b32 s35, 21
    s_cselect_b32 s55, s42, s41
    s_add_u32 s35, s36, 417792
    s_bitcmp1_b32 s35, 21
    s_cselect_b32 s56, s42, s41
    s_xor_b32 s41, s41, s42
    s_cmp_lg_u32 s28, 0
    s_cbranch_scc1 L_w1
    s_waitcnt vmcnt(6)
L_w1:
    s_waitcnt vmcnt(30)
    ds_read_b128 v[192:195], v1 offset:0
    ds_read_b128 v[196:199], v1 offset:64
    ds_read_b128 v[200:203], v1 offset:128
    ds_read_b128 v[204:207], v1 offset:192
    ds_read_b128 v[208:211], v1 offset:256
    ds_read_b128 v[212:215], v1 offset:320
    ds_read_b128 v[120:123], v8 offset:0
    ds_read_b128 v[124:127], v9 offset:0
    ds_read_b128 v[128:131], v8 offset:128
    ds_read_b128 v[132:135], v9 offset:128
    ds_read_b128 v[136:139], v8 offset:256
    ds_read_b128 v[140:143], v9 offset:256
    s_waitcnt lgkmcnt(11)
    v_lshlrev_b32 v47, 16, v192
    v_and_b32 v48, s34, v192
    v_lshlrev_b32 v49, 16, v193
    v_and_b32 v50, s34, v193
    v_lshlrev_b32 v51, 16, v194
    v_and_b32 v52, s34, v194
    v_lshlrev_b32 v53, 16, v195
    v_and_b32 v54, s34, v195
    s_waitcnt lgkmcnt(10)
    v_lshlrev_b32 v55, 16, v196
    v_and_b32 v56, s34, v196
    v_lshlrev_b32 v57, 16, v197
    v_and_b32 v58, s34, v197
    v_lshlrev_b32 v59, 16, v198
    v_and_b32 v60, s34, v198
    v_lshlrev_b32 v61, 16, v199
    v_and_b32 v62, s34, v199
    s_waitcnt lgkmcnt(9)
    v_lshlrev_b32 v63, 16, v200
    v_and_b32 v64, s34, v200
    v_lshlrev_b32 v65, 16, v201
    v_and_b32 v66, s34, v201
    v_lshlrev_b32 v67, 16, v202
    v_and_b32 v68, s34, v202
    v_lshlrev_b32 v69, 16, v203
    v_and_b32 v70, s34, v203
    s_waitcnt lgkmcnt(8)
    v_lshlrev_b32 v71, 16, v204
    v_and_b32 v72, s34, v204
    v_lshlrev_b32 v73, 16, v205
    v_and_b32 v74, s34, v205
    v_lshlrev_b32 v75, 16, v206
    v_and_b32 v76, s34, v206
    v_lshlrev_b32 v77, 16, v207
    v_and_b32 v78, s34, v207
    s_waitcnt lgkmcnt(7)
    v_lshlrev_b32 v79, 16, v208
    v_and_b32 v80, s34, v208
    v_lshlrev_b32 v81, 16, v209
    v_and_b32 v82, s34, v209
    v_lshlrev_b32 v83, 16, v210
    v_and_b32 v84, s34, v210
    v_lshlrev_b32 v85, 16, v211
    v_and_b32 v86, s34, v211
    s_waitcnt lgkmcnt(6)
    v_lshlrev_b32 v87, 16, v212
    v_and_b32 v88, s34, v212
    v_lshlrev_b32 v89, 16, v213
    v_and_b32 v90, s34, v213
    v_lshlrev_b32 v91, 16, v214
    v_and_b32 v92, s34, v214
    v_lshlrev_b32 v93, 16, v215
    v_and_b32 v94, s34, v215
    s_waitcnt lgkmcnt(0)
    v_lshlrev_b32 v22, 16, v120
    v_and_b32 v23, s34, v120
    v_lshlrev_b32 v24, 16, v121
    v_and_b32 v25, s34, v121
    v_lshlrev_b32 v26, 16, v122
    v_and_b32 v27, s34, v122
    v_lshlrev_b32 v28, 16, v123
    v_and_b32 v29, s34, v123
    v_mul_f32 v22, v22, v47
    v_mul_f32 v23, v23, v48
    v_mul_f32 v24, v24, v49
    v_mul_f32 v25, v25, v50
    v_mul_f32 v26, v26, v51
    v_mul_f32 v27, v27, v52
    v_mul_f32 v28, v28, v53
    v_mul_f32 v29, v29, v54
    v_cvt_pk_bf16_f32 v96, v22, v23
    v_cvt_pk_bf16_f32 v97, v24, v25
    v_cvt_pk_bf16_f32 v98, v26, v27
    v_cvt_pk_bf16_f32 v99, v28, v29
    v_lshlrev_b32 v30, 16, v124
    v_and_b32 v31, s34, v124
    v_lshlrev_b32 v32, 16, v125
    v_and_b32 v33, s34, v125
    v_lshlrev_b32 v34, 16, v126
    v_and_b32 v35, s34, v126
    v_lshlrev_b32 v36, 16, v127
    v_and_b32 v37, s34, v127
    v_mul_f32 v30, v30, v55
    v_mul_f32 v31, v31, v56
    v_mul_f32 v32, v32, v57
    v_mul_f32 v33, v33, v58
    v_mul_f32 v34, v34, v59
    v_mul_f32 v35, v35, v60
    v_mul_f32 v36, v36, v61
    v_mul_f32 v37, v37, v62
    v_cvt_pk_bf16_f32 v100, v30, v31
    v_cvt_pk_bf16_f32 v101, v32, v33
    v_cvt_pk_bf16_f32 v102, v34, v35
    v_cvt_pk_bf16_f32 v103, v36, v37
    v_lshlrev_b32 v22, 16, v128
    v_and_b32 v23, s34, v128
    v_lshlrev_b32 v24, 16, v129
    v_and_b32 v25, s34, v129
    v_lshlrev_b32 v26, 16, v130
    v_and_b32 v27, s34, v130
    v_lshlrev_b32 v28, 16, v131
    v_and_b32 v29, s34, v131
    v_mul_f32 v22, v22, v63
    v_mul_f32 v23, v23, v64
    v_mul_f32 v24, v24, v65
    v_mul_f32 v25, v25, v66
    v_mul_f32 v26, v26, v67
    v_mul_f32 v27, v27, v68
    v_mul_f32 v28, v28, v69
    v_mul_f32 v29, v29, v70
    v_cvt_pk_bf16_f32 v104, v22, v23
    v_cvt_pk_bf16_f32 v105, v24, v25
    v_cvt_pk_bf16_f32 v106, v26, v27
    v_cvt_pk_bf16_f32 v107, v28, v29
    v_lshlrev_b32 v30, 16, v132
    v_and_b32 v31, s34, v132
    v_lshlrev_b32 v32, 16, v133
    v_and_b32 v33, s34, v133
    v_lshlrev_b32 v34, 16, v134
    v_and_b32 v35, s34, v134
    v_lshlrev_b32 v36, 16, v135
    v_and_b32 v37, s34, v135
    v_mul_f32 v30, v30, v71
    v_mul_f32 v31, v31, v72
    v_mul_f32 v32, v32, v73
    v_mul_f32 v33, v33, v74
    v_mul_f32 v34, v34, v75
    v_mul_f32 v35, v35, v76
    v_mul_f32 v36, v36, v77
    v_mul_f32 v37, v37, v78
    v_cvt_pk_bf16_f32 v108, v30, v31
    v_cvt_pk_bf16_f32 v109, v32, v33
    v_cvt_pk_bf16_f32 v110, v34, v35
    v_cvt_pk_bf16_f32 v111, v36, v37
    s_waitcnt vmcnt(6)
    s_barrier
    s_cmp_lg_u32 s28, 0
    s_cbranch_scc1 L_nolate
    s_cmp_lg_u32 s44, 0
    s_cbranch_scc1 L_nolate
    s_and_b32 s35, s45, 63
    s_lshl_b32 s35, s35, 2
    s_lshr_b32 s36, s45, 6
    s_lshl_b32 s36, s36, 1
    s_add_u32 s36, s36, s43
    s_lshl_b32 s44, 1, s36
    v_mov_b32 v10, s35
    v_mov_b32 v11, s44
    s_mov_b64 exec, 1
    global_atomic_or v21, v10, v11, s[62:63] sc0
    s_mov_b64 exec, -1
L_nolate:
    s_add_u32 m0, s32, 12288
    s_nop 0
    buffer_load_dwordx4 v2, s[12:15], s50 offen offset:0 nt lds
    buffer_load_dwordx4 v3, s[12:15], s50 offen offset:1024 nt lds
    buffer_load_dwordx4 v4, s[12:15], s50 offen offset:2048 nt lds
    s_add_u32 m0, s32, 15360
    s_nop 0
    buffer_load_dwordx4 v5, s[12:15], s50 offen offset:0 nt lds
    buffer_load_dwordx4 v6, s[12:15], s50 offen offset:1024 nt lds
    buffer_load_dwordx4 v7, s[12:15], s50 offen offset:2048 nt lds
    ds_read_b64_tr_b16 a[0:1], v17 offset:0
    ds_read_b64_tr_b16 a[2:3], v17 offset:1536
    ds_read_b64_tr_b16 a[24:25], v18 offset:0
    ds_read_b64_tr_b16 a[26:27], v18 offset:1536
    ds_read_b64_tr_b16 a[48:49], v19 offset:0
    ds_read_b64_tr_b16 a[50:51], v19 offset:1536
    ds_read_b64_tr_b16 a[72:73], v20 offset:0
    ds_read_b64_tr_b16 a[74:75], v20 offset:1536
    ds_read_b64_tr_b16 a[96:97], v17 offset:128
    ds_read_b64_tr_b16 a[98:99], v17 offset:1664
    ds_read_b64_tr_b16 a[120:121], v18 offset:128
    ds_read_b64_tr_b16 a[122:123], v18 offset:1664
    ds_read_b64_tr_b16 a[144:145], v19 offset:128
    ds_read_b64_tr_b16 a[146:147], v19 offset:1664
    ds_read_b64_tr_b16 a[168:169], v20 offset:128
    ds_read_b64_tr_b16 a[170:171], v20 offset:1664
    ds_read_b64_tr_b16 a[192:193], v17 offset:256
    ds_read_b64_tr_b16 a[194:195], v17 offset:1792
    ds_read_b64_tr_b16 a[216:217], v18 offset:256
    ds_read_b64_tr_b16 a[218:219], v18 offset:1792
    ds_read_b64_tr_b16 a[240:241], v19 offset:256
    ds_read_b64_tr_b16 a[242:243], v19 offset:1792
    ds_read_b64_tr_b16 v[224:225], v20 offset:256
    ds_read_b64_tr_b16 v[226:227], v20 offset:1792
    ds_read_b64_tr_b16 a[4:5], v17 offset:12288
    ds_read_b64_tr_b16 a[6:7], v17 offset:13824
    ds_read_b64_tr_b16 a[28:29], v18 offset:12288
    ds_read_b64_tr_b16 a[30:31], v18 offset:13824
    ds_read_b64_tr_b16 a[52:53], v19 offset:12288
    ds_read_b64_tr_b16 a[54:55], v19 offset:13824
    ds_read_b64_tr_b16 a[76:77], v20 offset:12288
    ds_read_b64_tr_b16 a[78:79], v20 offset:13824
    ds_read_b64_tr_b16 a[100:101], v17 offset:12416
    ds_read_b64_tr_b16 a[102:103], v17 offset:13952
    ds_read_b64_tr_b16 a[124:125], v18 offset:12416
    ds_read_b64_tr_b16 a[126:127], v18 offset:13952
    ds_read_b64_tr_b16 a[148:149], v19 offset:12416
    ds_read_b64_tr_b16 a[150:151], v19 offset:13952
    ds_read_b64_tr_b16 a[172:173], v20 offset:12416
    ds_read_b64_tr_b16 a[174:175], v20 offset:13952
    ds_read_b64_tr_b16 a[196:197], v17 offset:12544
    ds_read_b64_tr_b16 a[198:199], v17 offset:14080
    ds_read_b64_tr_b16 a[220:221], v18 offset:12544
    ds_read_b64_tr_b16 a[222:223], v18 offset:14080
    ds_read_b64_tr_b16 a[244:245], v19 offset:12544
    ds_read_b64_tr_b16 a[246:247], v19 offset:14080
    ds_read_b64_tr_b16 v[228:229], v20 offset:12544
    ds_read_b64_tr_b16 v[230:231], v20 offset:14080
    v_add_u32 v17, 43008, v17
    v_add_u32 v18, 43008, v18
    v_add_u32 v19, 43008, v19
    v_add_u32 v20, 43008, v20
    ds_read_b64_tr_b16 a[8:9], v17 offset:0
    ds_read_b64_tr_b16 a[10:11], v17 offset:1536
    ds_read_b64_tr_b16 a[32:33], v18 offset:0
    ds_read_b64_tr_b16 a[34:35], v18 offset:1536
    ds_read_b64_tr_b16 a[56:57], v19 offset:0
    ds_read_b64_tr_b16 a[58:59], v19 offset:1536
    ds_read_b64_tr_b16 a[80:81], v20 offset:0
    ds_read_b64_tr_b16 a[82:83], v20 offset:1536
    ds_read_b64_tr_b16 a[104:105], v17 offset:128
    ds_read_b64_tr_b16 a[106:107], v17 offset:1664
    ds_read_b64_tr_b16 a[128:129], v18 offset:128
    ds_read_b64_tr_b16 a[130:131], v18 offset:1664
    ds_read_b64_tr_b16 a[152:153], v19 offset:128
    ds_read_b64_tr_b16 a[154:155], v19 offset:1664
    ds_read_b64_tr_b16 a[176:177], v20 offset:128
    ds_read_b64_tr_b16 a[178:179], v20 offset:1664
    ds_read_b64_tr_b16 a[200:201], v17 offset:256
    ds_read_b64_tr_b16 a[202:203], v17 offset:1792
    ds_read_b64_tr_b16 a[224:225], v18 offset:256
    ds_read_b64_tr_b16 a[226:227], v18 offset:1792
    ds_read_b64_tr_b16 a[248:249], v19 offset:256
    ds_read_b64_tr_b16 a[250:251], v19 offset:1792
    ds_read_b64_tr_b16 v[232:233], v20 offset:256
    ds_read_b64_tr_b16 v[234:235], v20 offset:1792
    ds_read_b64_tr_b16 a[12:13], v17 offset:30720
    ds_read_b64_tr_b16 a[14:15], v17 offset:32256
    ds_read_b64_tr_b16 a[36:37], v18 offset:30720
    ds_read_b64_tr_b16 a[38:39], v18 offset:32256
    ds_read_b64_tr_b16 a[60:61], v19 offset:30720
    ds_read_b64_tr_b16 a[62:63], v19 offset:32256
    ds_read_b64_tr_b16 a[84:85], v20 offset:30720
    ds_read_b64_tr_b16 a[86:87], v20 offset:32256
    ds_read_b64_tr_b16 a[108:109], v17 offset:30848
    ds_read_b64_tr_b16 a[110:111], v17 offset:32384
    ds_read_b64_tr_b16 a[132:133], v18 offset:30848
    ds_read_b64_tr_b16 a[134:135], v18 offset:32384
    ds_read_b64_tr_b16 a[156:157], v19 offset:30848
    ds_read_b64_tr_b16 a[158:159], v19 offset:32384
    ds_read_b64_tr_b16 a[180:181], v20 offset:30848
    ds_read_b64_tr_b16 a[182:183], v20 offset:32384
    ds_read_b64_tr_b16 a[204:205], v17 offset:30976
    ds_read_b64_tr_b16 a[206:207], v17 offset:32512
    ds_read_b64_tr_b16 a[228:229], v18 offset:30976
    ds_read_b64_tr_b16 a[230:231], v18 offset:32512
    ds_read_b64_tr_b16 a[252:253], v19 offset:30976
    ds_read_b64_tr_b16 a[254:255], v19 offset:32512
    ds_read_b64_tr_b16 v[236:237], v20 offset:30976
    ds_read_b64_tr_b16 v[238:239], v20 offset:32512
    v_add_u32 v17, 61440, v17
    v_add_u32 v18, 61440, v18
    v_add_u32 v19, 61440, v19
    v_add_u32 v20, 61440, v20
    ds_read_b64_tr_b16 a[16:17], v17 offset:0
    ds_read_b64_tr_b16 a[18:19], v17 offset:1536
    ds_read_b64_tr_b16 a[40:41], v18 offset:0
    ds_read_b64_tr_b16 a[42:43], v18 offset:1536
    ds_read_b64_tr_b16 a[64:65], v19 offset:0
    ds_read_b64_tr_b16 a[66:67], v19 offset:1536
    ds_read_b64_tr_b16 a[88:89], v20 offset:0
    ds_read_b64_tr_b16 a[90:91], v20 offset:1536
    ds_read_b64_tr_b16 a[112:113], v17 offset:128
    ds_read_b64_tr_b16 a[114:115], v17 offset:1664
    ds_read_b64_tr_b16 a[136:137], v18 offset:128
    ds_read_b64_tr_b16 a[138:139], v18 offset:1664
    ds_read_b64_tr_b16 a[160:161], v19 offset:128
    ds_read_b64_tr_b16 a[162:163], v19 offset:1664
    ds_read_b64_tr_b16 a[184:185], v20 offset:128
    ds_read_b64_tr_b16 a[186:187], v20 offset:1664
    ds_read_b64_tr_b16 a[208:209], v17 offset:256
    ds_read_b64_tr_b16 a[210:211], v17 offset:1792
    ds_read_b64_tr_b16 a[232:233], v18 offset:256
    ds_read_b64_tr_b16 a[234:235], v18 offset:1792
    ds_read_b64_tr_b16 v[216:217], v19 offset:256
    ds_read_b64_tr_b16 v[218:219], v19 offset:1792
    ds_read_b64_tr_b16 v[240:241], v20 offset:256
    ds_read_b64_tr_b16 v[242:243], v20 offset:1792
    ds_read_b64_tr_b16 a[20:21], v17 offset:30720
    ds_read_b64_tr_b16 a[22:23], v17 offset:32256
    ds_read_b64_tr_b16 a[44:45], v18 offset:30720
    ds_read_b64_tr_b16 a[46:47], v18 offset:32256
    ds_read_b64_tr_b16 a[68:69], v19 offset:30720
    ds_read_b64_tr_b16 a[70:71], v19 offset:32256
    ds_read_b64_tr_b16 a[92:93], v20 offset:30720
    ds_read_b64_tr_b16 a[94:95], v20 offset:32256
    ds_read_b64_tr_b16 a[116:117], v17 offset:30848
    ds_read_b64_tr_b16 a[118:119], v17 offset:32384
    ds_read_b64_tr_b16 a[140:141], v18 offset:30848
    ds_read_b64_tr_b16 a[142:143], v18 offset:32384
    ds_read_b64_tr_b16 a[164:165], v19 offset:30848
    ds_read_b64_tr_b16 a[166:167], v19 offset:32384
    ds_read_b64_tr_b16 a[188:189], v20 offset:30848
    ds_read_b64_tr_b16 a[190:191], v20 offset:32384
    ds_read_b64_tr_b16 a[212:213], v17 offset:30976
    ds_read_b64_tr_b16 a[214:215], v17 offset:32512
    ds_read_b64_tr_b16 a[236:237], v18 offset:30976
    ds_read_b64_tr_b16 a[238:239], v18 offset:32512
    ds_read_b64_tr_b16 v[220:221], v19 offset:30976
    ds_read_b64_tr_b16 v[222:223], v19 offset:32512
    ds_read_b64_tr_b16 v[244:245], v20 offset:30976
    ds_read_b64_tr_b16 v[246:247], v20 offset:32512
    s_cmp_lg_u32 s28, 0
    s_cbranch_scc1 L_nopub
    s_waitcnt vmcnt(6)
    v_readfirstlane_b32 s35, v21
    v_mov_b32 v23, 147456
    s_nop 2
    s_and_b32 s35, s35, s44
    s_cselect_b32 s35, 1, 0
    s_xor_b32 s43, s43, s35
    v_mov_b32 v25, s43
    ds_write_b32 v23, v25
L_nopub:
    s_waitcnt lgkmcnt(0)
    s_barrier
    v_mov_b32 v23, 147456
    ds_read_b32 v23, v23
    s_waitcnt lgkmcnt(0)
    v_readfirstlane_b32 s43, v23
    s_nop 3
    s_cmp_lg_u32 s43, 0
    s_cselect_b32 s41, s41, 0
    s_xor_b32 s51, s51, s41
    s_add_u32 s51, s51, s40
    s_add_u32 m0, s32, 18432
    s_nop 0
    buffer_load_dwordx4 v2, s[12:15], s51 offen offset:0 nt lds
    buffer_load_dwordx4 v3, s[12:15], s51 offen offset:1024 nt lds
    buffer_load_dwordx4 v4, s[12:15], s51 offen offset:2048 nt lds
    s_add_u32 m0, s32, 21504
    s_nop 0
    buffer_load_dwordx4 v5, s[12:15], s51 offen offset:0 nt lds
    buffer_load_dwordx4 v6, s[12:15], s51 offen offset:1024 nt lds
    buffer_load_dwordx4 v7, s[12:15], s51 offen offset:2048 nt lds
    s_add_u32 s40, s40, 49152
    s_xor_b32 s52, s52, s41
    s_add_u32 s52, s52, s40
    s_add_u32 s40, s40, 49152
    s_xor_b32 s53, s53, s41
    s_add_u32 s53, s53, s40
    s_add_u32 s40, s40, 49152
    s_xor_b32 s54, s54, s41
    s_add_u32 s54, s54, s40
    s_add_u32 s40, s40, 49152
    s_xor_b32 s55, s55, s41
    s_add_u32 s55, s55, s40
    s_add_u32 s40, s40, 49152
    s_xor_b32 s56, s56, s41
    s_add_u32 s56, s56, s40
    .p2align 3
L_loop:
    v_mfma_f32_16x16x32_bf16 v[144:147], a[0:3], v[96:99], 0
    ds_write_b64 v12, v[38:39] offset:256
    v_cvt_pk_bf16_f32 v40, v180, v181
    v_cvt_pk_bf16_f32 v41, v182, v183
    v_mfma_f32_16x16x32_bf16 v[148:151], a[24:27], v[96:99], 0
    ds_write_b64 v13, v[40:41] offset:256
    v_cvt_pk_bf16_f32 v42, v184, v185
    v_cvt_pk_bf16_f32 v43, v186, v187
    v_mfma_f32_16x16x32_bf16 v[152:155], a[48:51], v[96:99], 0
    s_cmp_lg_u32 s33, 6
    ds_write_b64 v14, v[42:43] offset:256
    v_cvt_pk_bf16_f32 v44, v188, v189
    v_cvt_pk_bf16_f32 v45, v190, v191
    v_mfma_f32_16x16x32_bf16 v[156:159], a[72:75], v[96:99], 0
    s_cbranch_scc1 L_nopark
    buffer_store_dwordx4 v[192:195], v2, s[24:27], s46 offen offset:0 sc1
    buffer_store_dwordx4 v[196:199], v3, s[24:27], s46 offen offset:1024 sc1
    buffer_store_dwordx4 v[200:203], v4, s[24:27], s46 offen offset:2048 sc1
    buffer_store_dwordx4 v[204:207], v5, s[24:27], s46 offen offset:0 sc1
    buffer_store_dwordx4 v[208:211], v6, s[24:27], s46 offen offset:1024 sc1
    buffer_store_dwordx4 v[212:215], v7, s[24:27], s46 offen offset:2048 sc1
L_nopark:
    ds_write_b64 v15, v[44:45] offset:256
    v_add_u32 v10, s31, v8
    v_add_u32 v11, s31, v9
    v_mfma_f32_16x16x32_bf16 v[160:163], a[96:99], v[96:99], 0
    ds_read_b128 v[192:195], v16 offset:0
    v_lshlrev_b32 v22, 16, v136
    v_and_b32 v23, s34, v136
    v_mfma_f32_16x16x32_bf16 v[164:167], a[120:123], v[96:99], 0
    ds_read_b128 v[196:199], v16 offset:1024
    v_lshlrev_b32 v24, 16, v137
    v_and_b32 v25, s34, v137
    v_mfma_f32_16x16x32_bf16 v[168:171], a[144:147], v[96:99], 0
    ds_read_b128 v[200:203], v16 offset:2048
    v_lshlrev_b32 v26, 16, v138
    v_and_b32 v27, s34, v138
    v_mfma_f32_16x16x32_bf16 v[172:175], a[168:171], v[96:99], 0
    ds_read_b128 v[204:207], v16 offset:3072
    v_lshlrev_b32 v28, 16, v139
    v_and_b32 v29, s34, v139
    v_mfma_f32_16x16x32_bf16 v[176:179], a[192:195], v[96:99], 0
    ds_read_b128 v[208:211], v16 offset:4096
    v_mul_f32 v22, v22, v79
    v_mul_f32 v23, v23, v80
    v_mfma_f32_16x16x32_bf16 v[180:183], a[216:219], v[96:99], 0
    ds_read_b128 v[212:215], v16 offset:5120
    v_mul_f32 v24, v24, v81
    v_mul_f32 v25, v25, v82
    v_mfma_f32_16x16x32_bf16 v[184:187], a[240:243], v[96:99], 0
    s_add_u32 s37, s32, s29
    v_mul_f32 v26, v26, v83
    v_mul_f32 v27, v27, v84
    v_mfma_f32_16x16x32_bf16 v[188:191], v[224:227], v[96:99], 0
    v_mul_f32 v28, v28, v85
    v_mul_f32 v29, v29, v86
    v_mfma_f32_16x16x32_bf16 v[144:147], a[4:7], v[100:103], v[144:147]
    v_cvt_pk_bf16_f32 v112, v22, v23
    v_cvt_pk_bf16_f32 v113, v24, v25
    v_mfma_f32_16x16x32_bf16 v[148:151], a[28:31], v[100:103], v[148:151]
    s_bitcmp1_b32 0x21, s33
    v_cvt_pk_bf16_f32 v114, v26, v27
    v_cvt_pk_bf16_f32 v115, v28, v29
    v_mfma_f32_16x16x32_bf16 v[152:155], a[52:55], v[100:103], v[152:155]
    s_waitcnt lgkmcnt(0)
    v_lshlrev_b32 v30, 16, v140
    v_and_b32 v31, s34, v140
    v_mfma_f32_16x16x32_bf16 v[156:159], a[76:79], v[100:103], v[156:159]
    s_cbranch_scc1 L_nostore
    buffer_store_dwordx4 v[192:195], v2, s[24:27], s47 offen offset:0 sc1
    buffer_store_dwordx4 v[196:199], v3, s[24:27], s47 offen offset:1024 sc1
    buffer_store_dwordx4 v[200:203], v4, s[24:27], s47 offen offset:2048 sc1
    buffer_store_dwordx4 v[204:207], v5, s[24:27], s47 offen offset:0 sc1
    buffer_store_dwordx4 v[208:211], v6, s[24:27], s47 offen offset:1024 sc1
    buffer_store_dwordx4 v[212:215], v7, s[24:27], s47 offen offset:2048 sc1
L_nostore:
    v_lshlrev_b32 v32, 16, v141
    v_and_b32 v33, s34, v141
    v_mfma_f32_16x16x32_bf16 v[160:163], a[100:103], v[100:103], v[160:163]
    s_cmp_lt_u32 s33, 5
    s_cbranch_scc0 L_noload
    s_barrier
    s_mov_b32 m0, s37
    s_nop 0
    buffer_load_dwordx4 v2, s[12:15], s52 offen offset:0 nt lds
    buffer_load_dwordx4 v3, s[12:15], s52 offen offset:1024 nt lds
    buffer_load_dwordx4 v4, s[12:15], s52 offen offset:2048 nt lds
    s_add_u32 m0, s37, 3072
    s_nop 0
    buffer_load_dwordx4 v5, s[12:15], s52 offen offset:0 nt lds
    buffer_load_dwordx4 v6, s[12:15], s52 offen offset:1024 nt lds
    buffer_load_dwordx4 v7, s[12:15], s52 offen offset:2048 nt lds
L_noload:
    v_lshlrev_b32 v34, 16, v142
    v_and_b32 v35, s34, v142
    v_mfma_f32_16x16x32_bf16 v[164:167], a[124:127], v[100:103], v[164:167]
    s_waitcnt vmcnt(18)
    ds_read_b128 v[120:123], v10 offset:0
    v_lshlrev_b32 v36, 16, v143
    v_and_b32 v37, s34, v143
    v_mfma_f32_16x16x32_bf16 v[168:171], a[148:151], v[100:103], v[168:171]
    ds_read_b128 v[124:127], v11 offset:0
    v_mul_f32 v30, v30, v87
    v_mul_f32 v31, v31, v88
    v_mfma_f32_16x16x32_bf16 v[172:175], a[172:175], v[100:103], v[172:175]
    ds_read_b128 v[128:131], v10 offset:128
    v_mul_f32 v32, v32, v89
    v_mul_f32 v33, v33, v90
    v_mfma_f32_16x16x32_bf16 v[176:179], a[196:199], v[100:103], v[176:179]
    ds_read_b128 v[132:135], v11 offset:128
    v_mul_f32 v34, v34, v91
    v_mul_f32 v35, v35, v92
    v_mfma_f32_16x16x32_bf16 v[180:183], a[220:223], v[100:103], v[180:183]
    ds_read_b128 v[136:139], v10 offset:256
    v_mul_f32 v36, v36, v93
    v_mul_f32 v37, v37, v94
    v_mfma_f32_16x16x32_bf16 v[184:187], a[244:247], v[100:103], v[184:187]
    ds_read_b128 v[140:143], v11 offset:256
    v_cvt_pk_bf16_f32 v116, v30, v31
    v_cvt_pk_bf16_f32 v117, v32, v33
    v_mfma_f32_16x16x32_bf16 v[188:191], v[228:231], v[100:103], v[188:191]
    s_waitcnt lgkmcnt(5)
    v_cvt_pk_bf16_f32 v118, v34, v35
    v_cvt_pk_bf16_f32 v119, v36, v37
    v_mfma_f32_16x16x32_bf16 v[144:147], a[8:11], v[104:107], v[144:147]
    v_lshlrev_b32 v22, 16, v120
    v_and_b32 v23, s34, v120
    v_mfma_f32_16x16x32_bf16 v[148:151], a[32:35], v[104:107], v[148:151]
    v_lshlrev_b32 v24, 16, v121
    v_and_b32 v25, s34, v121
    v_mfma_f32_16x16x32_bf16 v[152:155], a[56:59], v[104:107], v[152:155]
    v_lshlrev_b32 v26, 16, v122
    v_and_b32 v27, s34, v122
    v_mfma_f32_16x16x32_bf16 v[156:159], a[80:83], v[104:107], v[156:159]
    v_lshlrev_b32 v28, 16, v123
    v_and_b32 v29, s34, v123
    v_mfma_f32_16x16x32_bf16 v[160:163], a[104:107], v[104:107], v[160:163]
    v_mul_f32 v22, v22, v47
    v_mul_f32 v23, v23, v48
    v_mfma_f32_16x16x32_bf16 v[164:167], a[128:131], v[104:107], v[164:167]
    v_mul_f32 v24, v24, v49
    v_mul_f32 v25, v25, v50
    v_mfma_f32_16x16x32_bf16 v[168:171], a[152:155], v[104:107], v[168:171]
    s_waitcnt lgkmcnt(0)
    v_mul_f32 v26, v26, v51
    v_mul_f32 v27, v27, v52
    v_mfma_f32_16x16x32_bf16 v[172:175], a[176:179], v[104:107], v[172:175]
    s_add_u32 s31, s31, 6144
    v_mul_f32 v28, v28, v53
    v_mul_f32 v29, v29, v54
    v_mfma_f32_16x16x32_bf16 v[176:179], a[200:203], v[104:107], v[176:179]
    s_cmp_lt_u32 s31, 30720
    v_cvt_pk_bf16_f32 v96, v22, v23
    v_cvt_pk_bf16_f32 v97, v24, v25
    v_mfma_f32_16x16x32_bf16 v[180:183], a[224:227], v[104:107], v[180:183]
    s_cselect_b32 s31, s31, 0
    v_cvt_pk_bf16_f32 v98, v26, v27
    v_cvt_pk_bf16_f32 v99, v28, v29
    v_mfma_f32_16x16x32_bf16 v[184:187], a[248:251], v[104:107], v[184:187]
    s_add_u32 s29, s29, 6144
    v_lshlrev_b32 v30, 16, v124
    v_and_b32 v31, s34, v124
    v_mfma_f32_16x16x32_bf16 v[188:191], v[232:235], v[104:107], v[188:191]
    s_cmp_lt_u32 s29, 30720
    v_lshlrev_b32 v32, 16, v125
    v_and_b32 v33, s34, v125
    v_mfma_f32_16x16x32_bf16 v[144:147], a[12:15], v[108:111], v[144:147]
    s_cselect_b32 s29, s29, 0
    v_lshlrev_b32 v34, 16, v126
    v_and_b32 v35, s34, v126
    v_mfma_f32_16x16x32_bf16 v[148:151], a[36:39], v[108:111], v[148:151]
    s_add_u32 s33, s33, 1
    v_lshlrev_b32 v36, 16, v127
    v_and_b32 v37, s34, v127
    v_mfma_f32_16x16x32_bf16 v[152:155], a[60:63], v[108:111], v[152:155]
    s_mov_b32 s46, s47
    v_mul_f32 v30, v30, v55
    v_mul_f32 v31, v31, v56
    v_mfma_f32_16x16x32_bf16 v[156:159], a[84:87], v[108:111], v[156:159]
    s_mov_b32 s47, s48
    v_mul_f32 v32, v32, v57
    v_mul_f32 v33, v33, v58
    v_mfma_f32_16x16x32_bf16 v[160:163], a[108:111], v[108:111], v[160:163]
    s_mov_b32 s48, s49
    v_mul_f32 v34, v34, v59
    v_mul_f32 v35, v35, v60
    v_mfma_f32_16x16x32_bf16 v[164:167], a[132:135], v[108:111], v[164:167]
    s_mov_b32 s49, s50
    v_mul_f32 v36, v36, v61
    v_mul_f32 v37, v37, v62
    v_mfma_f32_16x16x32_bf16 v[168:171], a[156:159], v[108:111], v[168:171]
    s_mov_b32 s50, s51
    v_cvt_pk_bf16_f32 v100, v30, v31
    v_cvt_pk_bf16_f32 v101, v32, v33
    v_mfma_f32_16x16x32_bf16 v[172:175], a[180:183], v[108:111], v[172:175]
    s_mov_b32 s51, s52
    v_cvt_pk_bf16_f32 v102, v34, v35
    v_cvt_pk_bf16_f32 v103, v36, v37
    v_mfma_f32_16x16x32_bf16 v[176:179], a[204:207], v[108:111], v[176:179]
    s_mov_b32 s52, s53
    v_lshlrev_b32 v22, 16, v128
    v_and_b32 v23, s34, v128
    v_mfma_f32_16x16x32_bf16 v[180:183], a[228:231], v[108:111], v[180:183]
    s_mov_b32 s53, s54
    v_lshlrev_b32 v24, 16, v129
    v_and_b32 v25, s34, v129
    v_mfma_f32_16x16x32_bf16 v[184:187], a[252:255], v[108:111], v[184:187]
    s_mov_b32 s54, s55
    v_lshlrev_b32 v26, 16, v130
    v_and_b32 v27, s34, v130
    v_mfma_f32_16x16x32_bf16 v[188:191], v[236:239], v[108:111], v[188:191]
    s_mov_b32 s55, s56
    v_lshlrev_b32 v28, 16, v131
    v_and_b32 v29, s34, v131
    v_mfma_f32_16x16x32_bf16 v[144:147], a[16:19], v[112:115], v[144:147]
    s_cmp_lt_u32 s33, 9
    v_mul_f32 v22, v22, v63
    v_mul_f32 v23, v23, v64
    v_mfma_f32_16x16x32_bf16 v[148:151], a[40:43], v[112:115], v[148:151]
    v_mul_f32 v24, v24, v65
    v_mul_f32 v25, v25, v66
    v_mfma_f32_16x16x32_bf16 v[152:155], a[64:67], v[112:115], v[152:155]
    v_mul_f32 v26, v26, v67
    v_mul_f32 v27, v27, v68
    v_mfma_f32_16x16x32_bf16 v[156:159], a[88:91], v[112:115], v[156:159]
    v_mul_f32 v28, v28, v69
    v_mul_f32 v29, v29, v70
    v_mfma_f32_16x16x32_bf16 v[160:163], a[112:115], v[112:115], v[160:163]
    v_cvt_pk_bf16_f32 v104, v22, v23
    v_cvt_pk_bf16_f32 v105, v24, v25
    v_mfma_f32_16x16x32_bf16 v[164:167], a[136:139], v[112:115], v[164:167]
    v_cvt_pk_bf16_f32 v106, v26, v27
    v_cvt_pk_bf16_f32 v107, v28, v29
    v_mfma_f32_16x16x32_bf16 v[168:171], a[160:163], v[112:115], v[168:171]
    v_lshlrev_b32 v30, 16, v132
    v_and_b32 v31, s34, v132
    v_mfma_f32_16x16x32_bf16 v[172:175], a[184:187], v[112:115], v[172:175]
    v_lshlrev_b32 v32, 16, v133
    v_and_b32 v33, s34, v133
    v_mfma_f32_16x16x32_bf16 v[176:179], a[208:211], v[112:115], v[176:179]
    v_lshlrev_b32 v34, 16, v134
    v_and_b32 v35, s34, v134
    v_mfma_f32_16x16x32_bf16 v[180:183], a[232:235], v[112:115], v[180:183]
    v_lshlrev_b32 v36, 16, v135
    v_and_b32 v37, s34, v135
    v_mfma_f32_16x16x32_bf16 v[184:187], v[216:219], v[112:115], v[184:187]
    v_mul_f32 v30, v30, v71
    v_mul_f32 v31, v31, v72
    v_mfma_f32_16x16x32_bf16 v[188:191], v[240:243], v[112:115], v[188:191]
    v_mul_f32 v32, v32, v73
    v_mul_f32 v33, v33, v74
    v_mfma_f32_16x16x32_bf16 v[144:147], a[20:23], v[116:119], v[144:147]
    v_mul_f32 v34, v34, v75
    v_mul_f32 v35, v35, v76
    v_mfma_f32_16x16x32_bf16 v[148:151], a[44:47], v[116:119], v[148:151]
    v_mul_f32 v36, v36, v77
    v_mul_f32 v37, v37, v78
    v_mfma_f32_16x16x32_bf16 v[152:155], a[68:71], v[116:119], v[152:155]
    v_cvt_pk_bf16_f32 v108, v30, v31
    v_cvt_pk_bf16_f32 v109, v32, v33
    v_mfma_f32_16x16x32_bf16 v[156:159], a[92:95], v[116:119], v[156:159]
    v_cvt_pk_bf16_f32 v110, v34, v35
    v_cvt_pk_bf16_f32 v111, v36, v37
    v_cvt_pk_bf16_f32 v38, v144, v145
    v_cvt_pk_bf16_f32 v39, v146, v147
    v_mfma_f32_16x16x32_bf16 v[160:163], a[116:119], v[116:119], v[160:163]
    ds_write_b64 v12, v[38:39] offset:0
    v_cvt_pk_bf16_f32 v40, v148, v149
    v_cvt_pk_bf16_f32 v41, v150, v151
    v_mfma_f32_16x16x32_bf16 v[164:167], a[140:143], v[116:119], v[164:167]
    ds_write_b64 v13, v[40:41] offset:0
    v_cvt_pk_bf16_f32 v42, v152, v153
    v_cvt_pk_bf16_f32 v43, v154, v155
    v_mfma_f32_16x16x32_bf16 v[168:171], a[164:167], v[116:119], v[168:171]
    ds_write_b64 v14, v[42:43] offset:0
    v_cvt_pk_bf16_f32 v44, v156, v157
    v_cvt_pk_bf16_f32 v45, v158, v159
    v_mfma_f32_16x16x32_bf16 v[172:175], a[188:191], v[116:119], v[172:175]
    ds_write_b64 v15, v[44:45] offset:0
    v_cvt_pk_bf16_f32 v38, v160, v161
    v_cvt_pk_bf16_f32 v39, v162, v163
    v_mfma_f32_16x16x32_bf16 v[176:179], a[212:215], v[116:119], v[176:179]
    ds_write_b64 v12, v[38:39] offset:128
    v_cvt_pk_bf16_f32 v40, v164, v165
    v_cvt_pk_bf16_f32 v41, v166, v167
    v_mfma_f32_16x16x32_bf16 v[180:183], a[236:239], v[116:119], v[180:183]
    ds_write_b64 v13, v[40:41] offset:128
    v_cvt_pk_bf16_f32 v42, v168, v169
    v_cvt_pk_bf16_f32 v43, v170, v171
    v_mfma_f32_16x16x32_bf16 v[184:187], v[220:223], v[116:119], v[184:187]
    ds_write_b64 v14, v[42:43] offset:128
    v_cvt_pk_bf16_f32 v44, v172, v173
    v_cvt_pk_bf16_f32 v45, v174, v175
    v_mfma_f32_16x16x32_bf16 v[188:191], v[244:247], v[116:119], v[188:191]
    ds_write_b64 v15, v[44:45] offset:128
    v_cvt_pk_bf16_f32 v38, v176, v177
    v_cvt_pk_bf16_f32 v39, v178, v179
    s_cbranch_scc1 L_loop
    ds_write_b64 v12, v[38:39] offset:256
    s_nop 1
    v_cvt_pk_bf16_f32 v40, v180, v181
    v_cvt_pk_bf16_f32 v41, v182, v183
    ds_write_b64 v13, v[40:41] offset:256
    v_cvt_pk_bf16_f32 v42, v184, v185
    v_cvt_pk_bf16_f32 v43, v186, v187
    ds_write_b64 v14, v[42:43] offset:256
    v_cvt_pk_bf16_f32 v44, v188, v189
    v_cvt_pk_bf16_f32 v45, v190, v191
    ds_write_b64 v15, v[44:45] offset:256
    ds_read_b128 v[192:195], v16 offset:0
    ds_read_b128 v[196:199], v16 offset:1024
    ds_read_b128 v[200:203], v16 offset:2048
    ds_read_b128 v[204:207], v16 offset:3072
    ds_read_b128 v[208:211], v16 offset:4096
    ds_read_b128 v[212:215], v16 offset:5120
    s_waitcnt lgkmcnt(5)
    buffer_store_dwordx4 v[192:195], v2, s[24:27], s47 offen offset:0 sc1
    s_waitcnt lgkmcnt(4)
    buffer_store_dwordx4 v[196:199], v3, s[24:27], s47 offen offset:1024 sc1
    s_waitcnt lgkmcnt(3)
    buffer_store_dwordx4 v[200:203], v4, s[24:27], s47 offen offset:2048 sc1
    s_waitcnt lgkmcnt(2)
    buffer_store_dwordx4 v[204:207], v5, s[24:27], s47 offen offset:0 sc1
    s_waitcnt lgkmcnt(1)
    buffer_store_dwordx4 v[208:211], v6, s[24:27], s47 offen offset:1024 sc1
    s_waitcnt lgkmcnt(0)
    buffer_store_dwordx4 v[212:215], v7, s[24:27], s47 offen offset:2048 sc1
L_end:
    s_endpgm
    .fill 2048, 4, 0xbf810000
.section .rodata,"a"
.p2align 6
.amdhsa_kernel standalone__depthwise_separable__vision_kernel
  .amdhsa_next_free_vgpr 512
  .amdhsa_next_free_sgpr 64
  .amdhsa_accum_offset 256
  .amdhsa_group_segment_fixed_size 0
  .amdhsa_kernarg_size 48
  .amdhsa_user_sgpr_count 2
  .amdhsa_user_sgpr_kernarg_segment_ptr 1
  .amdhsa_system_sgpr_workgroup_id_x 1
  .amdhsa_float_denorm_mode_32 3
.end_amdhsa_kernel
```
